```python
import torch

def _softmax(x, axis=-1):
    return torch.softmax(x, dim=axis)
def _gelu(x):
    return torch.nn.functional.gelu(x, approximate="tanh")
def _silu(x):
    return torch.nn.functional.silu(x)
def _sigmoid(x):
    return torch.sigmoid(x)
def _layernorm(x, axis=-1, eps=1e-5):
    m = x.mean(dim=axis, keepdim=True)
    v = x.var(dim=axis, keepdim=True, unbiased=False)
    return (x - m) / torch.sqrt(v + eps)
def _scatter_add(tgt, idx, src, axis=0):
    return tgt.clone().index_add_(axis, idx, src)
def _segment_sum(src, seg, n):
    out = torch.zeros((n,) + src.shape[1:], dtype=src.dtype)
    return out.index_add_(0, seg, src)
def _pad(x, pw):
    flat = tuple(v for pair in reversed(pw) for v in pair)
    return torch.nn.functional.pad(x, flat)

kernel_name = 'standalone__paged_block_table_kv_radixattention__sampling'

def setup_inputs():

    _w = (lambda a: (lambda t: t.to(torch.bfloat16) if t.is_floating_point() else t)(torch.as_tensor(a)))
    B, H, Hkv, Dh = 8, 32, 32, 128
    Lk = 2048
    bs = 16
    nb = max(2, Lk // bs)
    P = max(1, nb // 2)
    n_phys = P + B * (nb - P)
    shared = torch.arange(P, dtype=torch.int64)
    priv = P + torch.arange(B * (nb - P), dtype=torch.int64).reshape(B, nb - P)
    bt = torch.cat([torch.tile(shared[None, :], (B, 1)), priv], dim=1)
    ctx = nb * bs - (torch.arange(1, B + 1, dtype=torch.int64) * 2654435761) % max(1, (nb * bs - P * bs) // 2)
    return {
        "q": _w((lambda *s: torch.randn(*s, dtype=torch.bfloat16) * 0.8)(B, H, Dh)),
        "k_cache": _w((lambda *s: torch.randn(*s, dtype=torch.bfloat16) * 0.8)(n_phys, bs, Hkv, Dh)),
        "v_cache": _w((lambda *s: torch.randn(*s, dtype=torch.bfloat16) * 0.05)(n_phys, bs, Hkv, Dh)),
        "block_table": _w(bt.to(torch.int64)),
        "ctx_lens": _w(torch.as_tensor(ctx).to(torch.int64)),
    }

def reference(q, k_cache, v_cache, block_table, ctx_lens):
    B, H, Dh = q.shape
    n_phys, bs, Hkv, _ = k_cache.shape
    nb = block_table.shape[1]
    Lk = nb * bs
    rep = H // Hkv
    k = k_cache[block_table].reshape(B, Lk, Hkv, Dh)
    v = v_cache[block_table].reshape(B, Lk, Hkv, Dh)
    k = (lambda x, n, axis: torch.repeat_interleave(x, n, dim=axis))(k, rep, axis=2)
    v = (lambda x, n, axis: torch.repeat_interleave(x, n, dim=axis))(v, rep, axis=2)
    scores = torch.einsum("bhd,bkhd->bhk", q, k) * (Dh ** -0.5)
    pos = torch.arange(Lk)
    valid = pos[None, :] < ctx_lens[:, None]
    scores = torch.where(valid[:, None, :], scores, -1e9)
    p = _softmax(scores, axis=-1)
    return torch.einsum("bhk,bkhd->bhd", p, v)
```

```asm
; @launch grid=(256,1,1) block=(320,1,1) lds=44544
.amdgcn_target "amdgcn-amd-amdhsa--gfx950"
.text
.globl standalone__paged_block_table_kv_radixattention__sampling_kernel
.p2align 8
.type standalone__paged_block_table_kv_radixattention__sampling_kernel,@function
standalone__paged_block_table_kv_radixattention__sampling_kernel:
    s_cmp_ge_u32 s2, 256
    s_cbranch_scc1 L_end
    s_load_dwordx16 s[4:19], s[0:1], 0
    s_getpc_b64 s[46:47]
L_pc:
    s_and_b32 s85, s2, 56
    s_lshl2_add_u32 s85, s85, L_guess-L_pc
    s_load_dwordx8 s[52:59], s[46:47], s85
    v_lshrrev_b32 v1, 6, v0
    v_and_b32 v0, 63, v0
    v_readfirstlane_b32 s3, v1
    s_and_b32 s60, s2, 7
    s_lshl_b32 s60, s60, 2
    s_lshr_b32 s60, 0x73406152, s60
    s_and_b32 s60, s60, 7
    s_lshr_b32 s85, s2, 6
    s_lshl3_add_u32 s60, s85, s60
    s_bfe_u32 s61, s2, 0x30003
    s_lshl_b32 s62, s60, 8
    s_cmp_eq_u32 s3, 0
    s_cbranch_scc1 L_helper
    s_sub_u32 s3, s3, 1
    s_mov_b32 m0, s3
    v_lshrrev_b32 v2, 4, v0
    v_bfe_u32 v4, v0, 1, 3
    v_and_b32 v5, 1, v0
    v_lshl_add_u32 v8, v4, 13, s62
    v_lshl_add_u32 v8, v2, 5, v8
    v_lshl_add_u32 v8, v5, 4, v8
    v_add_u32 v9, 0x10000, v8
    s_mov_b32 s22, 75497472
    s_mov_b32 s23, 0x20000
    s_waitcnt lgkmcnt(0)
    s_movrels_b32 s81, s52
    s_movrels_b32 s82, s56
    s_mov_b32 s20, s6
    s_and_b32 s21, s7, 0xffff
    buffer_load_dwordx4 v[84:87], v8, s[20:23], s81 offen offset:0 nt
    buffer_load_dwordx4 v[88:91], v8, s[20:23], s81 offen offset:128 nt
    buffer_load_dwordx4 v[92:95], v9, s[20:23], s81 offen offset:0 nt
    buffer_load_dwordx4 v[96:99], v9, s[20:23], s81 offen offset:128 nt
    buffer_load_dwordx4 v[100:103], v8, s[20:23], s82 offen offset:0 nt
    buffer_load_dwordx4 v[104:107], v8, s[20:23], s82 offen offset:128 nt
    buffer_load_dwordx4 v[108:111], v9, s[20:23], s82 offen offset:0 nt
    buffer_load_dwordx4 v[112:115], v9, s[20:23], s82 offen offset:128 nt
    s_mov_b32 s32, s4
    s_and_b32 s33, s5, 0xffff
    s_mov_b32 s34, 65536
    s_mov_b32 s35, 0x20000
    s_mov_b32 s40, s12
    s_and_b32 s41, s13, 0xffff
    s_mov_b32 s42, 32
    s_mov_b32 s43, 0x20000
    s_mov_b32 s24, s8
    s_and_b32 s25, s9, 0xffff
    s_mov_b32 s26, 75497472
    s_mov_b32 s27, 0x20000
    v_and_b32 v3, 15, v0
    v_lshl_add_u32 v10, v2, 14, s62
    v_lshl_add_u32 v10, v3, 4, v10
    v_add_u32 v11, 0x2000, v10
    v_add_u32 v12, 0x10000, v10
    v_add_u32 v13, 0x12000, v10
    v_lshlrev_b32 v6, 2, v4
    buffer_load_dwordx4 v[28:31], v8, s[32:35], 0 offen
    buffer_load_dwordx4 v[32:35], v8, s[32:35], 0 offen offset:128
    buffer_load_dword v14, v6, s[40:43], 0 offen
    s_mov_b32 s74, 0xaaaaaaaa
    s_mov_b32 s75, 0xaaaaaaaa
    s_mov_b32 s76, 0x00030003
    s_mov_b32 s77, 0x00030003
    s_mov_b32 s78, 0x05040100
    s_mov_b32 s79, 0x07060302
    s_mov_b32 s80, 0x3e0293ee
    v_mov_b32 v15, 0xff800000
    v_mov_b32 v7, 0xffff0000
    v_mov_b32 v16, 0xffff
    v_cndmask_b32 v16, v16, v7, s[74:75]
    v_lshl_add_u32 v7, v2, 1, v5
    v_mov_b32 v152, 0x3f803f80
    v_mov_b32 v153, 0x3f803f80
    v_mov_b32 v154, 0x3f803f80
    v_mov_b32 v155, 0x3f803f80
    s_lshl_b32 s85, s3, 1
    v_add_u32 v3, s85, v5
    v_lshlrev_b32 v156, 3, v3
    v_add_u32 v156, 2048, v156
    v_lshl_add_u32 v3, v3, 2, v2
    v_mul_u32_u24 v19, 144, v3
    v_add_u32 v19, 2560, v19
    s_lshl_b32 s98, s61, 1
    s_lshl_b64 s[50:51], s[76:77], s98
    v_lshrrev_b32 v1, 1, v0
    v_mad_u32_u24 v1, v1, 8, s85
    v_add_lshl_u32 v1, v1, v5, 3
    v_mov_b32 v52, 0
    v_mov_b32 v53, 0
    v_mov_b32 v54, 0
    v_mov_b32 v55, 0
    v_mov_b32 v56, 0
    v_mov_b32 v57, 0
    v_mov_b32 v58, 0
    v_mov_b32 v59, 0
    v_mov_b32 v60, 0
    v_mov_b32 v61, 0
    v_mov_b32 v62, 0
    v_mov_b32 v63, 0
    v_mov_b32 v64, 0
    v_mov_b32 v65, 0
    v_mov_b32 v66, 0
    v_mov_b32 v67, 0
    v_mov_b32 v68, 0
    v_mov_b32 v69, 0
    v_mov_b32 v70, 0
    v_mov_b32 v71, 0
    v_mov_b32 v72, 0
    v_mov_b32 v73, 0
    v_mov_b32 v74, 0
    v_mov_b32 v75, 0
    v_mov_b32 v76, 0
    v_mov_b32 v77, 0
    v_mov_b32 v78, 0
    v_mov_b32 v79, 0
    v_mov_b32 v80, 0
    v_mov_b32 v81, 0
    v_mov_b32 v82, 0
    v_mov_b32 v83, 0
    v_mov_b32 v148, 0
    v_mov_b32 v149, 0
    v_mov_b32 v150, 0
    v_mov_b32 v151, 0
    v_mov_b32 v17, 0xf149f2ca
    v_mov_b32 v18, 0xefce03f9
    s_mov_b32 s67, 0
    s_waitcnt vmcnt(8)
    buffer_load_dwordx4 v[116:119], v10, s[24:27], s81 offen nt
    s_waitcnt vmcnt(8)
    buffer_load_dwordx4 v[120:123], v11, s[24:27], s81 offen nt
    s_waitcnt vmcnt(8)
    buffer_load_dwordx4 v[124:127], v12, s[24:27], s81 offen nt
    s_waitcnt vmcnt(8)
    buffer_load_dwordx4 v[128:131], v13, s[24:27], s81 offen nt
    s_waitcnt vmcnt(8)
    buffer_load_dwordx4 v[132:135], v10, s[24:27], s82 offen nt
    s_waitcnt vmcnt(8)
    buffer_load_dwordx4 v[136:139], v11, s[24:27], s82 offen nt
    s_barrier
    ds_read_b64 v[20:21], v1 offset:0
    s_waitcnt vmcnt(6)
    v_cmp_lt_i32 vcc, 0, v14
    v_mov_b32 v2, 0x800
    v_min_i32 v14, v14, v2
    v_cndmask_b32 v14, v2, v14, vcc
    v_cndmask_b32 v28, 0, v28, vcc
    v_cndmask_b32 v29, 0, v29, vcc
    v_cndmask_b32 v30, 0, v30, vcc
    v_cndmask_b32 v31, 0, v31, vcc
    v_cndmask_b32 v32, 0, v32, vcc
    v_cndmask_b32 v33, 0, v33, vcc
    v_cndmask_b32 v34, 0, v34, vcc
    v_cndmask_b32 v35, 0, v35, vcc
    v_sub_u32 v14, v14, v7
    s_waitcnt lgkmcnt(0)
    v_readlane_b32 s85, v20, 0
    v_readlane_b32 s98, v20, 1
    s_nop 1
    s_xor_b32 s46, s85, s81
    s_xor_b32 s47, s98, s82
    s_or_b32 s46, s46, s47
    s_cbranch_scc1 L_redo
L_loop:
    s_add_u32 s85, s67, 1
    s_add_u32 s98, s67, 2
    s_add_u32 s99, s67, 3
    s_mov_b32 s45, s81
    s_mov_b32 s48, s82
    v_readlane_b32 s83, v21, s67
    v_readlane_b32 s84, v21, s85
    v_readlane_b32 s81, v20, s98
    v_readlane_b32 s82, v20, s99
    s_mov_b32 s67, s98
    s_mov_b32 s44, s83
    s_bitcmp0_b32 s44, 18
    s_cbranch_scc1 L_nt
    v_mov_b32 v1, 2112
    v_mov_b32 v4, 1
    ds_write_b32 v1, v4 offset:4
L_nt:
    s_and_b32 s85, s83, 7
    s_lshl_b32 s85, s85, 1
    s_lshl_b64 s[86:87], s[76:77], s85
    s_bitcmp1_b32 s83, 3
    s_cselect_b64 s[86:87], -1, s[86:87]
    s_and_b32 s83, s83, 0x400007f0
    v_subrev_u32 v22, s83, v14
    v_cndmask_b32 v22, -1, v22, s[86:87]
    s_and_b32 s85, s84, 7
    s_lshl_b32 s85, s85, 1
    s_lshl_b64 s[88:89], s[76:77], s85
    s_bitcmp1_b32 s84, 3
    s_cselect_b64 s[88:89], -1, s[88:89]
    s_and_b32 s84, s84, 0x400007f0
    v_subrev_u32 v23, s84, v14
    v_cndmask_b32 v23, -1, v23, s[88:89]
    v_cmp_lt_i32 s[90:91], 0, v22
    v_cmp_lt_i32 s[92:93], 8, v22
    v_cmp_lt_i32 s[94:95], 0, v23
    v_cmp_lt_i32 s[96:97], 8, v23
    s_waitcnt vmcnt(6)
    v_mfma_f32_16x16x32_bf16 v[36:39], v[84:87], v[28:31], 0
    v_mfma_f32_16x16x32_bf16 v[40:43], v[92:95], v[28:31], 0
    v_mfma_f32_16x16x32_bf16 v[44:47], v[100:103], v[28:31], 0
    v_mfma_f32_16x16x32_bf16 v[48:51], v[108:111], v[28:31], 0
    v_mfma_f32_16x16x32_bf16 v[36:39], v[88:91], v[32:35], v[36:39]
    v_mfma_f32_16x16x32_bf16 v[40:43], v[96:99], v[32:35], v[40:43]
    v_mfma_f32_16x16x32_bf16 v[44:47], v[104:107], v[32:35], v[44:47]
    v_mfma_f32_16x16x32_bf16 v[48:51], v[112:115], v[32:35], v[48:51]
    s_waitcnt vmcnt(5)
    buffer_load_dwordx4 v[140:143], v12, s[24:27], s48 offen nt
    s_nop 4
    v_add_f32_dpp v36, v37, v36 quad_perm:[1,0,3,2] row_mask:0xf bank_mask:0xf
    v_add_f32_dpp v39, v38, v39 quad_perm:[1,0,3,2] row_mask:0xf bank_mask:0xf
    v_add_f32_dpp v40, v41, v40 quad_perm:[1,0,3,2] row_mask:0xf bank_mask:0xf
    v_add_f32_dpp v43, v42, v43 quad_perm:[1,0,3,2] row_mask:0xf bank_mask:0xf
    v_add_f32_dpp v44, v45, v44 quad_perm:[1,0,3,2] row_mask:0xf bank_mask:0xf
    v_add_f32_dpp v47, v46, v47 quad_perm:[1,0,3,2] row_mask:0xf bank_mask:0xf
    v_add_f32_dpp v48, v49, v48 quad_perm:[1,0,3,2] row_mask:0xf bank_mask:0xf
    v_add_f32_dpp v51, v50, v51 quad_perm:[1,0,3,2] row_mask:0xf bank_mask:0xf
    v_cndmask_b32 v36, v36, v39, s[74:75]
    v_cndmask_b32 v40, v40, v43, s[74:75]
    v_cndmask_b32 v44, v44, v47, s[74:75]
    v_cndmask_b32 v48, v48, v51, s[74:75]
    v_cndmask_b32 v36, v15, v36, s[90:91]
    v_cndmask_b32 v40, v15, v40, s[92:93]
    v_cndmask_b32 v44, v15, v44, s[94:95]
    v_cndmask_b32 v48, v15, v48, s[96:97]
    v_max3_f32 v1, v36, v40, v44
    v_max3_f32 v1, v1, v48, v17
    v_mov_b32 v2, v1
    s_nop 1
    v_permlane16_swap_b32 v2, v1
    v_max_f32 v1, v2, v1
    v_mov_b32 v2, v1
    s_nop 1
    v_permlane32_swap_b32 v2, v1
    v_max_f32 v17, v2, v1
    s_waitcnt vmcnt(5)
    buffer_load_dwordx4 v[144:147], v13, s[24:27], s48 offen nt
    v_mul_f32 v1, s80, v17
    v_sub_f32 v2, v18, v1
    v_mov_b32 v18, v1
    v_exp_f32 v2, v2
    v_fma_f32 v37, v36, s80, -v1
    v_fma_f32 v41, v40, s80, -v1
    v_fma_f32 v45, v44, s80, -v1
    v_fma_f32 v49, v48, s80, -v1
    v_exp_f32 v37, v37
    v_exp_f32 v41, v41
    v_exp_f32 v45, v45
    v_exp_f32 v49, v49
    v_pk_mul_f32 v[52:53], v[52:53], v[2:3] op_sel_hi:[1,0]
    v_pk_mul_f32 v[54:55], v[54:55], v[2:3] op_sel_hi:[1,0]
    v_pk_mul_f32 v[56:57], v[56:57], v[2:3] op_sel_hi:[1,0]
    v_pk_mul_f32 v[58:59], v[58:59], v[2:3] op_sel_hi:[1,0]
    v_cvt_pk_bf16_f32 v24, v37, v37
    v_cvt_pk_bf16_f32 v25, v41, v41
    v_cvt_pk_bf16_f32 v26, v45, v45
    v_cvt_pk_bf16_f32 v27, v49, v49
    v_mul_f32 v148, v148, v2
    v_and_b32 v24, v16, v24
    v_and_b32 v25, v16, v25
    v_and_b32 v26, v16, v26
    v_and_b32 v27, v16, v27
    v_pk_mul_f32 v[60:61], v[60:61], v[2:3] op_sel_hi:[1,0]
    v_pk_mul_f32 v[62:63], v[62:63], v[2:3] op_sel_hi:[1,0]
    v_pk_mul_f32 v[64:65], v[64:65], v[2:3] op_sel_hi:[1,0]
    v_pk_mul_f32 v[66:67], v[66:67], v[2:3] op_sel_hi:[1,0]
    v_pk_mul_f32 v[68:69], v[68:69], v[2:3] op_sel_hi:[1,0]
    v_pk_mul_f32 v[70:71], v[70:71], v[2:3] op_sel_hi:[1,0]
    v_pk_mul_f32 v[72:73], v[72:73], v[2:3] op_sel_hi:[1,0]
    v_pk_mul_f32 v[74:75], v[74:75], v[2:3] op_sel_hi:[1,0]
    v_pk_mul_f32 v[76:77], v[76:77], v[2:3] op_sel_hi:[1,0]
    v_pk_mul_f32 v[78:79], v[78:79], v[2:3] op_sel_hi:[1,0]
    v_pk_mul_f32 v[80:81], v[80:81], v[2:3] op_sel_hi:[1,0]
    v_pk_mul_f32 v[82:83], v[82:83], v[2:3] op_sel_hi:[1,0]
    v_mfma_f32_16x16x32_bf16 v[148:151], v[152:155], v[24:27], v[148:151]
    s_bitcmp0_b32 s44, 17
    s_cbranch_scc0 L_k1
    s_waitcnt vmcnt(5)
    buffer_load_dwordx4 v[84:87], v8, s[20:23], s81 offen offset:0 nt
    s_waitcnt vmcnt(5)
    buffer_load_dwordx4 v[88:91], v8, s[20:23], s81 offen offset:128 nt
    s_waitcnt vmcnt(5)
    buffer_load_dwordx4 v[92:95], v9, s[20:23], s81 offen offset:0 nt
    s_waitcnt vmcnt(5)
    buffer_load_dwordx4 v[96:99], v9, s[20:23], s81 offen offset:128 nt
    s_waitcnt vmcnt(5)
    buffer_load_dwordx4 v[100:103], v8, s[20:23], s82 offen offset:0 nt
    s_waitcnt vmcnt(5)
    buffer_load_dwordx4 v[104:107], v8, s[20:23], s82 offen offset:128 nt
    s_waitcnt vmcnt(6)
    s_branch L_k2
L_k1:
    s_waitcnt vmcnt(0)
L_k2:
    v_perm_b32 v36, v120, v116, s78
    v_perm_b32 v37, v128, v124, s78
    v_perm_b32 v38, v136, v132, s78
    v_perm_b32 v39, v144, v140, s78
    v_perm_b32 v40, v120, v116, s79
    v_perm_b32 v41, v128, v124, s79
    v_perm_b32 v42, v136, v132, s79
    v_perm_b32 v43, v144, v140, s79
    v_mfma_f32_16x16x32_bf16 v[52:55], v[36:39], v[24:27], v[52:55]
    s_cbranch_scc0 L_kt6
    s_waitcnt vmcnt(5)
    buffer_load_dwordx4 v[108:111], v9, s[20:23], s82 offen offset:0 nt
L_kt6:
    v_perm_b32 v44, v121, v117, s78
    v_perm_b32 v45, v129, v125, s78
    v_perm_b32 v46, v137, v133, s78
    v_perm_b32 v47, v145, v141, s78
    v_mfma_f32_16x16x32_bf16 v[56:59], v[40:43], v[24:27], v[56:59]
    v_perm_b32 v36, v121, v117, s79
    v_perm_b32 v37, v129, v125, s79
    v_perm_b32 v38, v137, v133, s79
    v_perm_b32 v39, v145, v141, s79
    v_mfma_f32_16x16x32_bf16 v[60:63], v[44:47], v[24:27], v[60:63]
    v_perm_b32 v40, v122, v118, s78
    v_perm_b32 v41, v130, v126, s78
    v_perm_b32 v42, v138, v134, s78
    v_perm_b32 v43, v146, v142, s78
    v_mfma_f32_16x16x32_bf16 v[64:67], v[36:39], v[24:27], v[64:67]
    s_cbranch_scc0 L_kt7
    s_waitcnt vmcnt(5)
    buffer_load_dwordx4 v[112:115], v9, s[20:23], s82 offen offset:128 nt
L_kt7:
    v_perm_b32 v44, v122, v118, s79
    v_perm_b32 v45, v130, v126, s79
    v_perm_b32 v46, v138, v134, s79
    v_perm_b32 v47, v146, v142, s79
    v_mfma_f32_16x16x32_bf16 v[68:71], v[40:43], v[24:27], v[68:71]
    v_perm_b32 v36, v123, v119, s78
    v_perm_b32 v37, v131, v127, s78
    v_perm_b32 v38, v139, v135, s78
    v_perm_b32 v39, v147, v143, s78
    v_mfma_f32_16x16x32_bf16 v[72:75], v[44:47], v[24:27], v[72:75]
    v_perm_b32 v40, v123, v119, s79
    v_perm_b32 v41, v131, v127, s79
    v_perm_b32 v42, v139, v135, s79
    v_perm_b32 v43, v147, v143, s79
    v_mfma_f32_16x16x32_bf16 v[76:79], v[36:39], v[24:27], v[76:79]
    s_nop 1
    v_mfma_f32_16x16x32_bf16 v[80:83], v[40:43], v[24:27], v[80:83]
    s_cbranch_scc0 L_v2
    s_waitcnt vmcnt(5)
    buffer_load_dwordx4 v[116:119], v10, s[24:27], s81 offen nt
    s_waitcnt vmcnt(5)
    buffer_load_dwordx4 v[120:123], v11, s[24:27], s81 offen nt
    s_waitcnt vmcnt(5)
    buffer_load_dwordx4 v[124:127], v12, s[24:27], s81 offen nt
    s_waitcnt vmcnt(5)
    buffer_load_dwordx4 v[128:131], v13, s[24:27], s81 offen nt
    s_waitcnt vmcnt(5)
    buffer_load_dwordx4 v[132:135], v10, s[24:27], s82 offen nt
    s_waitcnt vmcnt(5)
    buffer_load_dwordx4 v[136:139], v11, s[24:27], s82 offen nt
L_v2:
    s_bitcmp1_b32 s44, 16
    s_cbranch_scc1 L_dump
L_nodump:
    s_bitcmp0_b32 s44, 17
    s_cbranch_scc1 L_loop
    s_mov_b64 exec, s[50:51]
    ds_write2_b32 v156, v18, v148 offset0:0 offset1:1
    ds_write2_b32 v19, v52, v56 offset0:0 offset1:1
    ds_write2_b32 v19, v53, v57 offset0:8 offset1:9
    ds_write2_b32 v19, v54, v58 offset0:16 offset1:17
    ds_write2_b32 v19, v55, v59 offset0:24 offset1:25
    ds_write2_b32 v19, v60, v64 offset0:2 offset1:3
    ds_write2_b32 v19, v61, v65 offset0:10 offset1:11
    ds_write2_b32 v19, v62, v66 offset0:18 offset1:19
    ds_write2_b32 v19, v63, v67 offset0:26 offset1:27
    ds_write2_b32 v19, v68, v72 offset0:4 offset1:5
    ds_write2_b32 v19, v69, v73 offset0:12 offset1:13
    ds_write2_b32 v19, v70, v74 offset0:20 offset1:21
    ds_write2_b32 v19, v71, v75 offset0:28 offset1:29
    ds_write2_b32 v19, v76, v80 offset0:6 offset1:7
    ds_write2_b32 v19, v77, v81 offset0:14 offset1:15
    ds_write2_b32 v19, v78, v82 offset0:22 offset1:23
    ds_write2_b32 v19, v79, v83 offset0:30 offset1:31
    s_waitcnt lgkmcnt(0)
    s_barrier
    s_endpgm
L_dump:
    s_mul_i32 s85, s3, 9344
    v_lshrrev_b32 v1, 4, v0
    v_add_lshl_u32 v1, v1, v0, 4
    v_add_u32 v1, s85, v1
    s_add_u32 s85, s85, 16000
    v_lshl_add_u32 v2, v0, 3, s85
    s_nop 4
    ds_write_b128 v1, v[52:55] offset:7168
    ds_write_b128 v1, v[56:59] offset:8272
    ds_write_b128 v1, v[60:63] offset:9376
    ds_write_b128 v1, v[64:67] offset:10480
    ds_write_b128 v1, v[68:71] offset:11584
    ds_write_b128 v1, v[72:75] offset:12688
    ds_write_b128 v1, v[76:79] offset:13792
    ds_write_b128 v1, v[80:83] offset:14896
    ds_write2_b32 v2, v18, v148 offset0:0 offset1:1
    v_mov_b32 v1, 2112
    v_lshlrev_b32 v2, s3, 1
    s_waitcnt lgkmcnt(0)
    s_mov_b64 exec, 1
    ds_or_b32 v1, v2
    s_mov_b64 exec, -1
    v_mov_b32 v52, 0
    v_mov_b32 v53, 0
    v_mov_b32 v54, 0
    v_mov_b32 v55, 0
    v_mov_b32 v56, 0
    v_mov_b32 v57, 0
    v_mov_b32 v58, 0
    v_mov_b32 v59, 0
    v_mov_b32 v60, 0
    v_mov_b32 v61, 0
    v_mov_b32 v62, 0
    v_mov_b32 v63, 0
    v_mov_b32 v64, 0
    v_mov_b32 v65, 0
    v_mov_b32 v66, 0
    v_mov_b32 v67, 0
    v_mov_b32 v68, 0
    v_mov_b32 v69, 0
    v_mov_b32 v70, 0
    v_mov_b32 v71, 0
    v_mov_b32 v72, 0
    v_mov_b32 v73, 0
    v_mov_b32 v74, 0
    v_mov_b32 v75, 0
    v_mov_b32 v76, 0
    v_mov_b32 v77, 0
    v_mov_b32 v78, 0
    v_mov_b32 v79, 0
    v_mov_b32 v80, 0
    v_mov_b32 v81, 0
    v_mov_b32 v82, 0
    v_mov_b32 v83, 0
    v_mov_b32 v148, 0
    v_mov_b32 v149, 0
    v_mov_b32 v150, 0
    v_mov_b32 v151, 0
    v_mov_b32 v17, 0xf149f2ca
    v_mov_b32 v18, 0xefce03f9
    s_branch L_nodump
L_redo:
    s_waitcnt vmcnt(0)
    s_mov_b32 s81, s85
    s_mov_b32 s82, s98
    buffer_load_dwordx4 v[84:87], v8, s[20:23], s81 offen offset:0 nt
    buffer_load_dwordx4 v[88:91], v8, s[20:23], s81 offen offset:128 nt
    buffer_load_dwordx4 v[92:95], v9, s[20:23], s81 offen offset:0 nt
    buffer_load_dwordx4 v[96:99], v9, s[20:23], s81 offen offset:128 nt
    buffer_load_dwordx4 v[100:103], v8, s[20:23], s82 offen offset:0 nt
    buffer_load_dwordx4 v[104:107], v8, s[20:23], s82 offen offset:128 nt
    buffer_load_dwordx4 v[108:111], v9, s[20:23], s82 offen offset:0 nt
    buffer_load_dwordx4 v[112:115], v9, s[20:23], s82 offen offset:128 nt
    s_waitcnt vmcnt(5)
    buffer_load_dwordx4 v[116:119], v10, s[24:27], s81 offen nt
    s_waitcnt vmcnt(5)
    buffer_load_dwordx4 v[120:123], v11, s[24:27], s81 offen nt
    s_waitcnt vmcnt(5)
    buffer_load_dwordx4 v[124:127], v12, s[24:27], s81 offen nt
    s_waitcnt vmcnt(5)
    buffer_load_dwordx4 v[128:131], v13, s[24:27], s81 offen nt
    s_waitcnt vmcnt(5)
    buffer_load_dwordx4 v[132:135], v10, s[24:27], s82 offen nt
    s_waitcnt vmcnt(5)
    buffer_load_dwordx4 v[136:139], v11, s[24:27], s82 offen nt
    s_branch L_loop
L_helper:
    s_memrealtime s[48:49]
    s_setprio 3
    v_lshlrev_b32 v1, 3, v0
    s_mov_b32 s30, 4096
    s_mov_b32 s31, 0x20000
    s_mov_b32 s34, 32
    s_mov_b32 s35, 0x20000
    v_and_b32 v18, 7, v0
    v_lshrrev_b32 v19, 3, v0
    v_lshlrev_b32 v6, 2, v18
    v_lshlrev_b32 v7, 2, v19
    v_mov_b32 v2, 2112
    v_mov_b32 v4, 0
    v_mov_b32 v5, 0
    ds_write_b64 v2, v[4:5]
    s_waitcnt lgkmcnt(0)
    s_mov_b32 s28, s10
    s_and_b32 s29, s11, 0xffff
    s_mov_b32 s32, s12
    s_and_b32 s33, s13, 0xffff
    buffer_load_dword v20, v6, s[32:35], 0 offen
    buffer_load_dword v21, v7, s[32:35], 0 offen
    buffer_load_dwordx2 v[116:117], v1, s[28:31], 0 offen offset:0
    buffer_load_dwordx2 v[118:119], v1, s[28:31], 0 offen offset:512
    buffer_load_dwordx2 v[120:121], v1, s[28:31], 0 offen offset:1024
    buffer_load_dwordx2 v[122:123], v1, s[28:31], 0 offen offset:1536
    buffer_load_dwordx2 v[124:125], v1, s[28:31], 0 offen offset:2048
    buffer_load_dwordx2 v[126:127], v1, s[28:31], 0 offen offset:2560
    buffer_load_dwordx2 v[128:129], v1, s[28:31], 0 offen offset:3072
    buffer_load_dwordx2 v[130:131], v1, s[28:31], 0 offen offset:3584
    s_mov_b32 s40, s16
    s_and_b32 s41, s17, 0xffff
    s_mov_b32 s42, 256
    s_mov_b32 s43, 0x20000
    s_mul_i32 s48, s48, 0x9e3779b1
    s_or_b32 s84, s48, 1
    s_lshl_b32 s79, s60, 3
    s_cmp_lg_u32 s61, 0
    s_cbranch_scc1 L_notag
    v_mov_b32 v132, s84
    s_mov_b64 exec, 1
    buffer_store_dword v132, off, s[40:43], s79 sc1
    s_mov_b64 exec, -1
    s_waitcnt vmcnt(9)
L_notag:
    v_add_u32 v1, 7168, v1
    v_mov_b32 v22, 0x800
    s_waitcnt vmcnt(8)
    v_cmp_lt_i32 s[86:87], 0, v20
    v_cmp_lt_i32 s[88:89], 0, v21
    v_min_i32 v20, v20, v22
    v_min_i32 v21, v21, v22
    v_cndmask_b32 v20, v22, v20, s[86:87]
    v_cndmask_b32 v21, v22, v21, s[88:89]
    v_add_u32 v20, 15, v20
    v_lshrrev_b32 v20, 4, v20
    v_add_u32 v21, 15, v21
    v_lshrrev_b32 v21, 4, v21
    v_mov_b32 v23, v20
    s_nop 1
    v_max_u32_dpp v23, v23, v23 quad_perm:[1,0,3,2] row_mask:0xf bank_mask:0xf
    s_nop 1
    v_max_u32_dpp v23, v23, v23 quad_perm:[2,3,0,1] row_mask:0xf bank_mask:0xf
    s_nop 1
    v_max_u32_dpp v23, v23, v23 row_half_mirror row_mask:0xf bank_mask:0xf
    s_nop 0
    v_readfirstlane_b32 s63, v23
    s_cmp_lg_u32 s61, 0
    s_cbranch_scc0 L_w1
    s_waitcnt vmcnt(0)
L_w1:
    s_waitcnt vmcnt(1)
    ds_write_b64 v1, v[116:117] offset:0
    ds_write_b64 v1, v[118:119] offset:512
    ds_write_b64 v1, v[120:121] offset:1024
    ds_write_b64 v1, v[122:123] offset:1536
    ds_write_b64 v1, v[124:125] offset:2048
    ds_write_b64 v1, v[126:127] offset:2560
    ds_write_b64 v1, v[128:129] offset:3072
    ds_write_b64 v1, v[130:131] offset:3584
    v_max3_u32 v8, v116, v118, v120
    v_min3_u32 v9, v116, v118, v120
    v_max3_u32 v8, v8, v122, v124
    v_min3_u32 v9, v9, v122, v124
    v_max3_u32 v8, v8, v126, v128
    v_min3_u32 v9, v9, v126, v128
    v_max_u32 v8, v8, v130
    v_min_u32 v9, v9, v130
    v_cmp_ne_u32 s[86:87], v8, v9
    v_max3_u32 v10, v117, v119, v121
    v_min3_u32 v11, v117, v119, v121
    v_max3_u32 v10, v10, v123, v125
    v_min3_u32 v11, v11, v123, v125
    v_max3_u32 v10, v10, v127, v129
    v_min3_u32 v11, v11, v127, v129
    v_max_u32 v10, v10, v131
    v_min_u32 v11, v11, v131
    v_cmp_ne_u32 s[88:89], v10, v11
    s_nop 1
    s_ff1_i32_b64 s85, s[86:87]
    s_ff1_i32_b64 s98, s[88:89]
    s_lshl_b32 s85, s85, 1
    s_lshl1_add_u32 s98, s98, 1
    s_min_u32 s63, s63, s85
    s_min_u32 s63, s63, s98
    v_subrev_u32 v20, s63, v20
    v_max_i32 v20, 0, v20
    v_subrev_u32 v21, s63, v21
    v_max_i32 v21, 0, v21
    v_mov_b32 v24, v20
    s_nop 1
    v_add_u32_dpp v24, v24, v24 quad_perm:[1,0,3,2] row_mask:0xf bank_mask:0xf
    s_nop 1
    v_add_u32_dpp v24, v24, v24 quad_perm:[2,3,0,1] row_mask:0xf bank_mask:0xf
    s_nop 1
    v_add_u32_dpp v24, v24, v24 row_half_mirror row_mask:0xf bank_mask:0xf
    v_add3_u32 v24, v24, s63, 7
    v_lshrrev_b32 v25, 3, v24
    v_min_u32 v26, v20, v25
    v_min_u32 v27, v21, v25
    v_sub_u32 v24, v25, v26
    v_sub_u32 v25, v25, v27
    v_sub_u32 v20, v20, v26
    v_lshlrev_b32 v22, 3, v24
    v_lshlrev_b32 v23, 3, v25
    v_sub_u32 v22, v22, v18
    v_sub_u32 v23, v23, v19
    v_cmp_gt_i32 s[86:87], v22, v23
    v_cmp_lt_u32 s[88:89], v18, v19
    v_lshlrev_b32 v23, 16, v20
    v_cndmask_b32 v22, 0, v24, s[86:87]
    v_cndmask_b32 v23, 0, v23, s[88:89]
    v_or_b32 v22, v22, v23
    s_nop 1
    v_add_u32_dpp v22, v22, v22 quad_perm:[1,0,3,2] row_mask:0xf bank_mask:0xf
    s_nop 1
    v_add_u32_dpp v22, v22, v22 quad_perm:[2,3,0,1] row_mask:0xf bank_mask:0xf
    s_nop 1
    v_add_u32_dpp v22, v22, v22 row_half_mirror row_mask:0xf bank_mask:0xf
    v_lshlrev_b32 v21, 5, v18
    v_lshrrev_b32 v23, 16, v22
    v_and_b32 v22, 0xffff, v22
    ds_bpermute_b32 v28, v21, v23
    v_readlane_b32 s85, v23, 56
    v_readlane_b32 s98, v20, 7
    s_lshl_b32 s99, s61, 3
    s_add_u32 s71, s85, s98
    s_add_u32 s71, s71, s63
    v_sub_u32 v29, s71, v22
    v_med3_i32 v29, v29, 0, v25
    v_readlane_b32 s65, v22, s99
    v_readlane_b32 s68, v27, s99
    v_readlane_b32 s66, v29, s99
    v_lshl_add_u32 v30, v18, 7, v26
    v_add3_u32 v30, v30, s63, v19
    v_mov_b32 v31, v19
    s_waitcnt lgkmcnt(0)
    v_add_lshl_u32 v32, v28, v19, 2
L_exc:
    v_cmp_lt_u32 vcc, v31, v20
    v_add_u32 v31, 8, v31
    s_mov_b64 exec, vcc
    ds_write_b32 v32, v30 offset:11264
    s_mov_b64 exec, -1
    v_cmp_lt_u32 vcc, v31, v20
    v_add_u32 v30, 8, v30
    v_add_u32 v32, 32, v32
    s_cbranch_vccnz L_exc
    s_add_u32 s69, s66, s68
    v_mov_b32 v1, v0
    s_lshl_b32 s85, s61, 7
    s_add_u32 s85, s85, s63
    v_mov_b32 v12, s85
    v_mov_b32 v13, 576
    s_mov_b32 s67, 3
L_items:
    v_and_b32 v10, -8, v1
    v_bfe_u32 v2, v1, 1, 2
    v_add_u32 v10, v10, v2
    v_and_b32 v2, 1, v1
    v_lshl_add_u32 v11, v2, 2, v10
    v_add_u32 v2, s65, v11
    v_subrev_u32 v3, s63, v2
    v_and_b32 v4, 0x3ff, v3
    v_lshlrev_b32 v4, 2, v4
    ds_read_b32 v4, v4 offset:11264
    v_cmp_gt_i32 s[90:91], 0, v3
    v_subrev_u32 v6, s66, v11
    v_cmp_gt_u32 s[92:93], s66, v11
    v_cmp_gt_u32 s[96:97], s68, v6
    v_add_u32 v6, v12, v6
    s_or_b64 s[96:97], s[96:97], s[92:93]
    s_and_b64 s[94:95], s[90:91], s[92:93]
    s_waitcnt lgkmcnt(0)
    v_cndmask_b32 v4, v4, v2, s[90:91]
    v_cndmask_b32 v4, v6, v4, s[92:93]
    v_bfe_u32 v3, v4, 7, 3
    v_and_b32 v5, 127, v4
    v_cndmask_b32 v3, v3, 8, s[94:95]
    v_and_b32 v4, 0x3ff, v4
    v_lshlrev_b32 v4, 2, v4
    ds_read_b32 v8, v4 offset:7168
    v_lshl_add_u32 v9, v5, 4, v3
    v_mov_b32 v6, 0x40000000
    v_cndmask_b32 v9, v6, v9, s[96:97]
    v_add_u32 v3, 8, v10
    v_add_u32 v4, 16, v10
    v_cmp_le_u32 s[90:91], s69, v3
    v_cmp_le_u32 s[92:93], s69, v4
    v_cmp_le_u32 s[94:95], s66, v3
    v_cmp_gt_u32 vcc, s66, v10
    s_and_b64 s[94:95], s[94:95], vcc
    v_or_b32 v2, 0x20000, v9
    v_cndmask_b32 v9, v9, v2, s[90:91]
    v_or_b32 v2, 0x40000, v9
    v_cndmask_b32 v9, v9, v2, s[92:93]
    v_or_b32 v2, 0x10000, v9
    v_cndmask_b32 v9, v9, v2, s[94:95]
    v_lshlrev_b32 v2, 3, v1
    v_add_u32 v1, 64, v1
    s_waitcnt lgkmcnt(0)
    v_cndmask_b32 v8, v13, v8, s[96:97]
    v_lshlrev_b32 v8, 17, v8
    ds_write_b64 v2, v[8:9] offset:0
    s_add_u32 s85, s69, 7
    v_readfirstlane_b32 s98, v1
    s_sub_u32 s67, s67, 1
    s_cbranch_scc1 L_itdone
    s_cmp_lt_u32 s98, s85
    s_cbranch_scc1 L_items
L_itdone:
    s_waitcnt lgkmcnt(0)
    s_barrier
    s_mov_b32 s36, s18
    s_and_b32 s37, s19, 0xffff
    s_mov_b32 s38, 1085440
    s_mov_b32 s39, 0x20000
    s_mov_b32 s32, s14
    s_and_b32 s33, s15, 0xffff
    s_mov_b32 s34, 65536
    s_mov_b32 s35, 0x20000
    v_add_u32 v28, s63, v28
    v_add_u32 v30, v22, v29
    v_cmp_gt_u32 s[86:87], v30, v28
    v_add_u32 v28, v28, v20
    v_cmp_lt_u32 s[88:89], 0, v20
    s_and_b64 s[86:87], s[86:87], s[88:89]
    v_cmp_lt_u32 s[88:89], v22, v28
    s_and_b64 s[86:87], s[86:87], s[88:89]
    v_cmp_gt_u32 s[88:89], s63, v22
    s_or_b64 s[86:87], s[86:87], s[88:89]
    v_cmp_lt_u32 s[88:89], 0, v29
    s_and_b64 s[86:87], s[86:87], s[88:89]
    v_cmp_ne_u32 s[88:89], v18, v19
    s_and_b64 s[72:73], s[86:87], s[88:89]
    s_cmp_eq_u32 s61, 0
    s_cbranch_scc1 L_tagok
    s_mov_b32 s67, 0
    s_mov_b64 exec, 1
L_tag:
    buffer_load_dword v132, off, s[40:43], s79 sc1
L_tag1:
    s_add_u32 s67, s67, 1
    s_waitcnt vmcnt(0)
    v_readfirstlane_b32 s84, v132
    s_nop 1
    s_cmp_lg_u32 s84, 0
    s_cbranch_scc1 L_tagin
    s_cmp_ge_u32 s67, 0x4000
    s_cbranch_scc1 L_tagin
    s_sleep 32
    s_branch L_tag
L_tagin:
    s_mov_b64 exec, -1
L_tagok:
    v_mov_b32 v132, s84
    s_getreg_b32 s78, hwreg(HW_REG_XCC_ID, 0, 4)
    s_lshl_b32 s79, s60, 7
    s_add_u32 s79, s79, 1081344
    s_lshl3_add_u32 s85, s61, s79
    v_mov_b32 v133, s78
    s_mov_b64 exec, 1
    buffer_store_dwordx2 v[132:133], off, s[36:39], s85
    s_mov_b64 exec, -1
    v_lshrrev_b32 v1, 5, v0
    v_and_b32 v2, 31, v0
    s_cmp_eq_u32 s66, 0
    s_cbranch_scc1 L_nopub
    v_mov_b32 v52, 0
    v_mov_b32 v53, 0
    v_mov_b32 v54, 0
    v_mov_b32 v55, 0
    v_mov_b32 v56, 0
    v_mov_b32 v57, 0
    v_mov_b32 v58, 0
    v_mov_b32 v59, 0
    v_mov_b32 v60, 0
    v_mov_b32 v61, 0
    v_mov_b32 v62, 0
    v_mov_b32 v63, 0
    v_mov_b32 v64, 0
    v_mov_b32 v65, 0
    v_mov_b32 v66, 0
    v_mov_b32 v67, 0
    v_mov_b32 v68, 0xefce03f9
    v_mov_b32 v72, 0
    v_mov_b32 v69, 0xefce03f9
    v_mov_b32 v73, 0
    v_mov_b32 v70, 0xefce03f9
    v_mov_b32 v74, 0
    v_mov_b32 v71, 0xefce03f9
    v_mov_b32 v75, 0
    v_lshrrev_b32 v3, 3, v2
    v_lshlrev_b32 v4, 4, v3
    v_lshl_add_u32 v4, v1, 1, v4
    v_lshlrev_b32 v9, 4, v1
    v_add_lshl_u32 v4, v4, v3, 4
    v_bfe_u32 v5, v2, 1, 2
    v_lshl_add_u32 v4, v5, 2, v4
    v_and_b32 v5, 1, v2
    v_mul_u32_u24 v5, 4416, v5
    v_add_u32 v5, v4, v5
    v_add_u32 v5, 7168, v5
    v_add_u32 v6, 1104, v5
    v_add_u32 v7, 2208, v5
    v_add_u32 v8, 3312, v5
    s_min_u32 s70, s66, 4
    v_mov_b32 v10, 2112
L_next:
    s_sub_u32 s70, s70, 1
L_spin1:
    ds_read_b32 v11, v10
    s_waitcnt lgkmcnt(0)
    v_readfirstlane_b32 s85, v11
    s_nop 1
    s_bitcmp1_b32 s85, s70
    s_cbranch_scc1 L_mrg
    s_sleep 3
    s_branch L_spin1
L_mrg:
    s_cmp_lg_u32 s70, 0
    s_cbranch_scc1 L_nocen
    v_lshlrev_b32 v138, 3, v0
    s_mov_b64 exec, 0xff
    buffer_load_dwordx2 v[136:137], v138, s[36:39], s79 offen sc1
    s_mov_b64 exec, -1
L_nocen:
    s_mul_i32 s85, s70, 9344
    v_add_u32 v13, s85, v5
    v_add_u32 v14, s85, v6
    v_add_u32 v15, s85, v7
    v_add_u32 v16, s85, v8
    v_add_u32 v17, s85, v9
    ds_read_b128 v[116:119], v17 offset:16000
    ds_read_b128 v[120:123], v17 offset:16032
    ds_read_b128 v[124:127], v17 offset:16064
    ds_read_b128 v[128:131], v17 offset:16096
    ds_read2_b32 v[84:85], v13 offset0:0 offset1:4
    ds_read2_b32 v[86:87], v14 offset0:0 offset1:4
    ds_read2_b32 v[88:89], v15 offset0:0 offset1:4
    ds_read2_b32 v[90:91], v16 offset0:0 offset1:4
    ds_read2_b32 v[92:93], v13 offset0:16 offset1:20
    ds_read2_b32 v[94:95], v14 offset0:16 offset1:20
    ds_read2_b32 v[96:97], v15 offset0:16 offset1:20
    ds_read2_b32 v[98:99], v16 offset0:16 offset1:20
    ds_read2_b32 v[100:101], v13 offset0:32 offset1:36
    ds_read2_b32 v[102:103], v14 offset0:32 offset1:36
    ds_read2_b32 v[104:105], v15 offset0:32 offset1:36
    ds_read2_b32 v[106:107], v16 offset0:32 offset1:36
    ds_read2_b32 v[108:109], v13 offset0:48 offset1:52
    ds_read2_b32 v[110:111], v14 offset0:48 offset1:52
    ds_read2_b32 v[112:113], v15 offset0:48 offset1:52
    ds_read2_b32 v[114:115], v16 offset0:48 offset1:52
    s_waitcnt lgkmcnt(15)
    v_max3_f32 v12, v68, v116, v118
    v_sub_f32 v76, v68, v12
    v_sub_f32 v116, v116, v12
    v_sub_f32 v118, v118, v12
    v_exp_f32 v76, v76
    v_exp_f32 v116, v116
    v_exp_f32 v118, v118
    v_mov_b32 v68, v12
    v_mul_f32 v72, v72, v76
    v_fmac_f32 v72, v116, v117
    v_fmac_f32 v72, v118, v119
    v_mul_f32 v52, v52, v76
    v_mul_f32 v53, v53, v76
    v_mul_f32 v54, v54, v76
    v_mul_f32 v55, v55, v76
    v_max3_f32 v12, v69, v120, v122
    v_sub_f32 v77, v69, v12
    v_sub_f32 v120, v120, v12
    v_sub_f32 v122, v122, v12
    v_exp_f32 v77, v77
    v_exp_f32 v120, v120
    v_exp_f32 v122, v122
    v_mov_b32 v69, v12
    v_mul_f32 v73, v73, v77
    v_fmac_f32 v73, v120, v121
    v_fmac_f32 v73, v122, v123
    v_mul_f32 v56, v56, v77
    v_mul_f32 v57, v57, v77
    v_mul_f32 v58, v58, v77
    v_mul_f32 v59, v59, v77
    v_max3_f32 v12, v70, v124, v126
    v_sub_f32 v78, v70, v12
    v_sub_f32 v124, v124, v12
    v_sub_f32 v126, v126, v12
    v_exp_f32 v78, v78
    v_exp_f32 v124, v124
    v_exp_f32 v126, v126
    v_mov_b32 v70, v12
    v_mul_f32 v74, v74, v78
    v_fmac_f32 v74, v124, v125
    v_fmac_f32 v74, v126, v127
    v_mul_f32 v60, v60, v78
    v_mul_f32 v61, v61, v78
    v_mul_f32 v62, v62, v78
    v_mul_f32 v63, v63, v78
    v_max3_f32 v12, v71, v128, v130
    v_sub_f32 v79, v71, v12
    v_sub_f32 v128, v128, v12
    v_sub_f32 v130, v130, v12
    v_exp_f32 v79, v79
    v_exp_f32 v128, v128
    v_exp_f32 v130, v130
    v_mov_b32 v71, v12
    v_mul_f32 v75, v75, v79
    v_fmac_f32 v75, v128, v129
    v_fmac_f32 v75, v130, v131
    v_mul_f32 v64, v64, v79
    v_mul_f32 v65, v65, v79
    v_mul_f32 v66, v66, v79
    v_mul_f32 v67, v67, v79
    s_waitcnt lgkmcnt(0)
    v_fmac_f32 v52, v116, v84
    v_fmac_f32 v52, v118, v85
    v_fmac_f32 v53, v116, v86
    v_fmac_f32 v53, v118, v87
    v_fmac_f32 v54, v116, v88
    v_fmac_f32 v54, v118, v89
    v_fmac_f32 v55, v116, v90
    v_fmac_f32 v55, v118, v91
    v_fmac_f32 v56, v120, v92
    v_fmac_f32 v56, v122, v93
    v_fmac_f32 v57, v120, v94
    v_fmac_f32 v57, v122, v95
    v_fmac_f32 v58, v120, v96
    v_fmac_f32 v58, v122, v97
    v_fmac_f32 v59, v120, v98
    v_fmac_f32 v59, v122, v99
    v_fmac_f32 v60, v124, v100
    v_fmac_f32 v60, v126, v101
    v_fmac_f32 v61, v124, v102
    v_fmac_f32 v61, v126, v103
    v_fmac_f32 v62, v124, v104
    v_fmac_f32 v62, v126, v105
    v_fmac_f32 v63, v124, v106
    v_fmac_f32 v63, v126, v107
    v_fmac_f32 v64, v128, v108
    v_fmac_f32 v64, v130, v109
    v_fmac_f32 v65, v128, v110
    v_fmac_f32 v65, v130, v111
    v_fmac_f32 v66, v128, v112
    v_fmac_f32 v66, v130, v113
    v_fmac_f32 v67, v128, v114
    v_fmac_f32 v67, v130, v115
    s_cmp_lg_u32 s70, 0
    s_cbranch_scc1 L_next
    s_mov_b32 s85, 0x07060500
    v_perm_b32 v52, v52, v132, s85
    v_perm_b32 v56, v56, v132, s85
    v_perm_b32 v60, v60, v132, s85
    v_perm_b32 v64, v64, v132, s85
    s_mov_b32 s85, 0x07060501
    v_perm_b32 v53, v53, v132, s85
    v_perm_b32 v57, v57, v132, s85
    v_perm_b32 v61, v61, v132, s85
    v_perm_b32 v65, v65, v132, s85
    s_mov_b32 s85, 0x07060502
    v_perm_b32 v54, v54, v132, s85
    v_perm_b32 v58, v58, v132, s85
    v_perm_b32 v62, v62, v132, s85
    v_perm_b32 v66, v66, v132, s85
    s_mov_b32 s85, 0x07060503
    v_perm_b32 v55, v55, v132, s85
    v_perm_b32 v59, v59, v132, s85
    v_perm_b32 v63, v63, v132, s85
    v_perm_b32 v67, v67, v132, s85
    v_lshlrev_b32 v6, 3, v1
    v_add_u32 v6, 2144, v6
    ds_write2_b32 v6, v68, v72 offset0:0 offset1:1
    ds_write2_b32 v6, v69, v73 offset0:4 offset1:5
    ds_write2_b32 v6, v70, v74 offset0:8 offset1:9
    ds_write2_b32 v6, v71, v75 offset0:12 offset1:13
    s_lshl_b32 s85, s61, 3
    s_lshr_b64 s[86:87], s[72:73], s85
    v_lshrrev_b32 v4, v1, s86
    v_lshlrev_b32 v5, 12, v1
    v_lshl_add_u32 v5, v2, 4, v5
    v_mov_b32 v9, 0x40000000
    s_lshl_b32 s85, s60, 6
    s_add_u32 s85, s85, s61
    s_lshl_b32 s85, s85, 9
    s_lshl_b32 s99, s60, 3
    s_add_u32 s99, s99, s61
    s_lshl_b32 s99, s99, 7
    s_add_u32 s99, s99, 1048576
    v_and_b32 v10, 1, v4
    v_cmp_ne_u32 vcc, 0, v10
    v_add_u32 v13, 0, v5
    s_nop 0
    v_cndmask_b32 v13, v9, v13, vcc
    v_and_b32 v10, 4, v4
    v_cmp_ne_u32 vcc, 0, v10
    v_add_u32 v14, 8192, v5
    s_nop 0
    v_cndmask_b32 v14, v9, v14, vcc
    v_and_b32 v10, 16, v4
    v_cmp_ne_u32 vcc, 0, v10
    v_add_u32 v15, 16384, v5
    s_nop 0
    v_cndmask_b32 v15, v9, v15, vcc
    v_and_b32 v10, 64, v4
    v_cmp_ne_u32 vcc, 0, v10
    v_add_u32 v16, 24576, v5
    s_nop 0
    v_cndmask_b32 v16, v9, v16, vcc
    v_lshlrev_b32 v7, 3, v0
    v_cmp_gt_u32 vcc, 8, v0
    v_lshlrev_b32 v17, 4, v0
    v_min_u32 v7, 56, v7
    v_cndmask_b32 v17, v9, v17, vcc
    s_waitcnt lgkmcnt(0)
    ds_read_b64 v[8:9], v7 offset:2144
    v_mov_b32 v10, v132
    v_mov_b32 v11, v132
    s_waitcnt vmcnt(0) lgkmcnt(0)
    v_cmp_eq_u32 s[88:89], s84, v136
    v_cmp_eq_u32 vcc, s78, v137
    v_mov_b32 v134, v8
    v_mov_b32 v135, v9
    s_and_b32 s98, s88, vcc_lo
    s_and_b32 s98, s98, 0xff
    s_cmp_eq_u32 s98, 0xff
    s_cbranch_scc0 L_st1
    buffer_store_dwordx4 v[52:55], v13, s[36:39], s85 offen
    buffer_store_dwordx4 v[56:59], v14, s[36:39], s85 offen
    buffer_store_dwordx4 v[60:63], v15, s[36:39], s85 offen
    buffer_store_dwordx4 v[64:67], v16, s[36:39], s85 offen
    buffer_store_dwordx4 v[8:11], v17, s[36:39], s99 offen
    s_branch L_nopub
L_st1:
    buffer_store_dwordx4 v[52:55], v13, s[36:39], s85 offen sc1
    buffer_store_dwordx4 v[56:59], v14, s[36:39], s85 offen sc1
    buffer_store_dwordx4 v[60:63], v15, s[36:39], s85 offen sc1
    buffer_store_dwordx4 v[64:67], v16, s[36:39], s85 offen sc1
    buffer_store_dwordx4 v[8:11], v17, s[36:39], s99 offen sc1
L_nopub:
    s_lshr_b64 s[86:87], s[72:73], s61
    v_lshlrev_b32 v3, 4, v0
    v_lshlrev_b32 v4, 3, v1
    v_lshrrev_b32 v18, v4, s86
    v_lshrrev_b32 v19, v4, s87
    v_mov_b32 v20, 0x40000000
    v_and_b32 v21, 0x1, v18
    v_cmp_ne_u32 s[90:91], 0, v21
    v_add_u32 v24, 0, v3
    s_nop 0
    v_cndmask_b32 v24, v20, v24, s[90:91]
    v_and_b32 v21, 0x10000, v18
    v_cmp_ne_u32 s[92:93], 0, v21
    v_add_u32 v25, 1024, v3
    s_nop 0
    v_cndmask_b32 v25, v20, v25, s[92:93]
    v_and_b32 v21, 0x1, v19
    v_cmp_ne_u32 s[94:95], 0, v21
    v_add_u32 v26, 2048, v3
    s_nop 0
    v_cndmask_b32 v26, v20, v26, s[94:95]
    v_and_b32 v21, 0x10000, v19
    v_cmp_ne_u32 s[96:97], 0, v21
    v_add_u32 v27, 3072, v3
    s_nop 0
    v_cndmask_b32 v27, v20, v27, s[96:97]
    v_lshlrev_b32 v4, 3, v0
    v_lshrrev_b64 v[18:19], v4, s[86:87]
    v_and_b32 v4, 1, v18
    v_cmp_gt_u32 s[88:89], 8, v0
    v_cmp_ne_u32 vcc, 0, v4
    v_lshlrev_b32 v28, 7, v0
    s_and_b64 s[88:89], s[88:89], vcc
    v_cndmask_b32 v28, v20, v28, s[88:89]
    s_lshl_b32 s85, s60, 3
    s_add_u32 s98, s85, s61
    s_lshl_b32 s98, s98, 12
    s_lshl_b32 s85, s85, 7
    s_lshl4_add_u32 s85, s61, s85
    s_add_u32 s85, s85, 1048576
    s_mov_b32 s86, 0
    s_mov_b32 s87, -1
    s_mov_b32 s56, 0x0c0c0400
    s_mov_b32 s57, 0x04000c0c
    v_lshrrev_b32 v3, 3, v2
    v_lshl_add_u32 v3, v1, 2, v3
    v_mul_u32_u24 v3, 144, v3
    v_and_b32 v4, 7, v2
    v_lshl_add_u32 v3, v4, 4, v3
    v_lshlrev_b32 v4, 3, v1
    v_mov_b32 v5, 2112
L_spin3:
    ds_read_b32 v6, v5 offset:4
    s_waitcnt lgkmcnt(0)
    v_readfirstlane_b32 s67, v6
    s_nop 1
    s_cmp_ge_u32 s67, 1
    s_cbranch_scc1 L_go
    s_sleep 4
    s_branch L_spin3
L_go:
    s_mov_b32 s67, 0
L_spin2:
    buffer_load_dwordx4 v[12:15], v28, s[36:39], s85 offen sc1
    buffer_load_dwordx4 v[84:87], v24, s[36:39], s98 offen sc1
    buffer_load_dwordx4 v[88:91], v25, s[36:39], s98 offen sc1
    buffer_load_dwordx4 v[92:95], v26, s[36:39], s98 offen sc1
    buffer_load_dwordx4 v[96:99], v27, s[36:39], s98 offen sc1
    s_add_u32 s67, s67, 1
    s_waitcnt vmcnt(4)
    v_cmp_ne_u32 vcc, s84, v14
    s_and_b64 s[58:59], vcc, s[88:89]
    s_waitcnt vmcnt(3)
    v_perm_b32 v16, v85, v84, s56
    v_perm_b32 v17, v87, v86, s57
    v_or_b32 v16, v16, v17
    v_cmp_ne_u32 vcc, s84, v16
    s_and_b64 vcc, vcc, s[90:91]
    s_or_b64 s[58:59], s[58:59], vcc
    s_waitcnt vmcnt(2)
    v_perm_b32 v16, v89, v88, s56
    v_perm_b32 v17, v91, v90, s57
    v_or_b32 v16, v16, v17
    v_cmp_ne_u32 vcc, s84, v16
    s_and_b64 vcc, vcc, s[92:93]
    s_or_b64 s[58:59], s[58:59], vcc
    s_waitcnt vmcnt(1)
    v_perm_b32 v16, v93, v92, s56
    v_perm_b32 v17, v95, v94, s57
    v_or_b32 v16, v16, v17
    v_cmp_ne_u32 vcc, s84, v16
    s_and_b64 vcc, vcc, s[94:95]
    s_or_b64 s[58:59], s[58:59], vcc
    s_waitcnt vmcnt(0)
    v_perm_b32 v16, v97, v96, s56
    v_perm_b32 v17, v99, v98, s57
    v_or_b32 v16, v16, v17
    v_cmp_ne_u32 vcc, s84, v16
    s_and_b64 vcc, vcc, s[96:97]
    s_or_b64 s[58:59], s[58:59], vcc
    s_cbranch_scc0 L_got
    s_cmp_ge_u32 s67, 0x4000
    s_cbranch_scc1 L_got
    s_sleep 16
    s_branch L_spin2
L_got:
    v_mov_b32 v7, 0xefce03f9
    v_cndmask_b32 v12, v7, v12, s[88:89]
    s_cmp_eq_u32 s66, 0
    s_cbranch_scc1 L_noown
    v_cmp_eq_u32 vcc, s61, v0
    v_subrev_u32 v8, v1, s61
    s_nop 0
    v_cndmask_b32 v12, v12, v134, vcc
    v_cndmask_b32 v13, v13, v135, vcc
    v_cmp_eq_u32 vcc, 0, v8
    s_nop 1
    v_cndmask_b32 v84, v84, v52, vcc
    v_cndmask_b32 v85, v85, v53, vcc
    v_cndmask_b32 v86, v86, v54, vcc
    v_cndmask_b32 v87, v87, v55, vcc
    v_cmp_eq_u32 vcc, 2, v8
    s_nop 1
    v_cndmask_b32 v88, v88, v56, vcc
    v_cndmask_b32 v89, v89, v57, vcc
    v_cndmask_b32 v90, v90, v58, vcc
    v_cndmask_b32 v91, v91, v59, vcc
    v_cmp_eq_u32 vcc, 4, v8
    s_nop 1
    v_cndmask_b32 v92, v92, v60, vcc
    v_cndmask_b32 v93, v93, v61, vcc
    v_cndmask_b32 v94, v94, v62, vcc
    v_cndmask_b32 v95, v95, v63, vcc
    v_cmp_eq_u32 vcc, 6, v8
    s_nop 1
    v_cndmask_b32 v96, v96, v64, vcc
    v_cndmask_b32 v97, v97, v65, vcc
    v_cndmask_b32 v98, v98, v66, vcc
    v_cndmask_b32 v99, v99, v67, vcc
L_noown:
    v_mov_b32 v8, v12
    s_nop 1
    v_max_f32_dpp v8, v8, v8 quad_perm:[1,0,3,2] row_mask:0xf bank_mask:0xf
    s_nop 1
    v_max_f32_dpp v8, v8, v8 quad_perm:[2,3,0,1] row_mask:0xf bank_mask:0xf
    s_nop 1
    v_max_f32_dpp v8, v8, v8 row_half_mirror row_mask:0xf bank_mask:0xf
    v_sub_f32 v12, v12, v8
    v_exp_f32 v12, v12
    v_readlane_b32 s52, v8, 0
    v_mul_f32 v13, v12, v13
    v_readlane_b32 s44, v12, 0
    v_readlane_b32 s45, v12, 1
    v_readlane_b32 s46, v12, 2
    v_readlane_b32 s47, v12, 3
    v_readlane_b32 s48, v12, 4
    v_readlane_b32 s49, v12, 5
    v_readlane_b32 s50, v12, 6
    v_readlane_b32 s51, v12, 7
    s_nop 1
    v_add_f32_dpp v13, v13, v13 quad_perm:[1,0,3,2] row_mask:0xf bank_mask:0xf
    s_nop 1
    v_add_f32_dpp v13, v13, v13 quad_perm:[2,3,0,1] row_mask:0xf bank_mask:0xf
    s_nop 1
    v_add_f32_dpp v13, v13, v13 row_half_mirror row_mask:0xf bank_mask:0xf
    v_mov_b32 v8, s44
    v_mov_b32 v9, s45
    v_cndmask_b32 v76, v8, v9, s[86:87]
    v_mov_b32 v8, s46
    v_mov_b32 v9, s47
    v_cndmask_b32 v77, v8, v9, s[86:87]
    v_mov_b32 v8, s48
    v_mov_b32 v9, s49
    v_cndmask_b32 v78, v8, v9, s[86:87]
    v_mov_b32 v8, s50
    v_mov_b32 v9, s51
    v_cndmask_b32 v79, v8, v9, s[86:87]
    v_readlane_b32 s53, v13, 0
    v_and_b32 v84, 0xffffff00, v84
    v_and_b32 v85, 0xffffff00, v85
    v_and_b32 v86, 0xffffff00, v86
    v_and_b32 v87, 0xffffff00, v87
    v_and_b32 v88, 0xffffff00, v88
    v_and_b32 v89, 0xffffff00, v89
    v_and_b32 v90, 0xffffff00, v90
    v_and_b32 v91, 0xffffff00, v91
    v_and_b32 v92, 0xffffff00, v92
    v_and_b32 v93, 0xffffff00, v93
    v_and_b32 v94, 0xffffff00, v94
    v_and_b32 v95, 0xffffff00, v95
    v_and_b32 v96, 0xffffff00, v96
    v_and_b32 v97, 0xffffff00, v97
    v_and_b32 v98, 0xffffff00, v98
    v_and_b32 v99, 0xffffff00, v99
    v_mul_f32 v52, v76, v84
    v_mul_f32 v53, v76, v85
    v_mul_f32 v54, v76, v86
    v_mul_f32 v55, v76, v87
    v_fmac_f32 v52, v77, v88
    v_fmac_f32 v53, v77, v89
    v_fmac_f32 v54, v77, v90
    v_fmac_f32 v55, v77, v91
    v_fmac_f32 v52, v78, v92
    v_fmac_f32 v53, v78, v93
    v_fmac_f32 v54, v78, v94
    v_fmac_f32 v55, v78, v95
    v_fmac_f32 v52, v79, v96
    v_fmac_f32 v53, v79, v97
    v_fmac_f32 v54, v79, v98
    v_fmac_f32 v55, v79, v99
    v_mov_b32 v16, s53
    v_cndmask_b32 v18, v16, 0, s[86:87]
    s_lshl_b32 s85, s61, 5
    s_add_u32 s85, s85, s60
    s_lshl_b32 s85, s85, 8
    v_lshlrev_b32 v7, 3, v2
    v_lshl_add_u32 v7, v1, 2, v7
    s_barrier
    ds_read_b64 v[8:9], v4 offset:2048
    ds_read_b64 v[10:11], v4 offset:2064
    ds_read_b64 v[12:13], v4 offset:2080
    ds_read_b64 v[14:15], v4 offset:2096
    ds_read_b128 v[84:87], v3 offset:2560
    ds_read_b128 v[88:91], v3 offset:3712
    ds_read_b128 v[92:95], v3 offset:4864
    ds_read_b128 v[96:99], v3 offset:6016
    s_waitcnt lgkmcnt(4)
    v_max3_f32 v20, v8, v10, s52
    v_max3_f32 v20, v20, v12, v14
    v_mov_b32 v21, v20
    s_nop 1
    v_permlane32_swap_b32 v21, v20
    v_max_f32 v20, v21, v20
    v_sub_f32 v16, s52, v20
    v_sub_f32 v8, v8, v20
    v_sub_f32 v10, v10, v20
    v_sub_f32 v12, v12, v20
    v_sub_f32 v14, v14, v20
    v_exp_f32 v16, v16
    v_exp_f32 v8, v8
    v_exp_f32 v10, v10
    v_exp_f32 v12, v12
    v_exp_f32 v14, v14
    v_mul_f32 v18, v18, v16
    v_pk_mul_f32 v[52:53], v[52:53], v[16:17] op_sel_hi:[1,0]
    v_pk_mul_f32 v[54:55], v[54:55], v[16:17] op_sel_hi:[1,0]
    v_fmac_f32 v18, v8, v9
    v_fmac_f32 v18, v10, v11
    v_fmac_f32 v18, v12, v13
    v_fmac_f32 v18, v14, v15
    s_waitcnt lgkmcnt(0)
    v_mov_b32 v19, v18
    v_pk_fma_f32 v[52:53], v[84:85], v[8:9], v[52:53] op_sel_hi:[1,0,1]
    v_pk_fma_f32 v[54:55], v[86:87], v[8:9], v[54:55] op_sel_hi:[1,0,1]
    v_permlane32_swap_b32 v19, v18
    v_add_f32 v18, v18, v19
    v_rcp_f32 v18, v18
    v_pk_fma_f32 v[52:53], v[88:89], v[10:11], v[52:53] op_sel_hi:[1,0,1]
    v_pk_fma_f32 v[54:55], v[90:91], v[10:11], v[54:55] op_sel_hi:[1,0,1]
    v_pk_fma_f32 v[52:53], v[92:93], v[12:13], v[52:53] op_sel_hi:[1,0,1]
    v_pk_fma_f32 v[54:55], v[94:95], v[12:13], v[54:55] op_sel_hi:[1,0,1]
    v_pk_fma_f32 v[52:53], v[96:97], v[14:15], v[52:53] op_sel_hi:[1,0,1]
    v_pk_fma_f32 v[54:55], v[98:99], v[14:15], v[54:55] op_sel_hi:[1,0,1]
    s_nop 1
    v_permlane32_swap_b32 v52, v54
    v_permlane32_swap_b32 v53, v55
    v_pk_add_f32 v[52:53], v[52:53], v[54:55]
    v_pk_mul_f32 v[52:53], v[52:53], v[18:19] op_sel_hi:[1,0]
    v_cvt_pk_bf16_f32 v10, v52, v53
    buffer_store_dword v10, v7, s[32:35], s85 offen
L_end:
    s_endpgm
.p2align 7
.type L_guess,@object
L_guess:
    .long 0x00280000
    .long 0x002a0000
    .long 0x002c0000
    .long 0x002e0000
    .long 0x00300000
    .long 0x00320000
    .long 0x00340000
    .long 0x00360000
    .long 0x006a0000
    .long 0x006c0000
    .long 0x006e0000
    .long 0x00700000
    .long 0x00720000
    .long 0x00740000
    .long 0x00760000
    .long 0x00780000
    .long 0x036e0000
    .long 0x03700000
    .long 0x03720000
    .long 0x03740000
    .long 0x03760000
    .long 0x03780000
    .long 0x037a0000
    .long 0x01800000
    .long 0x02000000
    .long 0x02020000
    .long 0x02040000
    .long 0x02060000
    .long 0x02080000
    .long 0x020a0000
    .long 0x020c0000
    .long 0x020e0000
    .long 0x02800000
    .long 0x02820000
    .long 0x02840000
    .long 0x02860000
    .long 0x02880000
    .long 0x028a0000
    .long 0x028c0000
    .long 0x028e0000
    .long 0x03000000
    .long 0x03020000
    .long 0x03040000
    .long 0x03060000
    .long 0x03080000
    .long 0x030a0000
    .long 0x030c0000
    .long 0x030e0000
    .long 0x00000000
    .long 0x00020000
    .long 0x00040000
    .long 0x00060000
    .long 0x00080000
    .long 0x000a0000
    .long 0x000c0000
    .long 0x000e0000
    .long 0x004c0000
    .long 0x004e0000
    .long 0x00500000
    .long 0x00520000
    .long 0x00540000
    .long 0x00560000
    .long 0x00580000
    .long 0x005a0000
.size L_guess, 256
.section .rodata,"a"
.p2align 6
.amdhsa_kernel standalone__paged_block_table_kv_radixattention__sampling_kernel
  .amdhsa_next_free_vgpr 157
  .amdhsa_next_free_sgpr 102
  .amdhsa_accum_offset 160
  .amdhsa_group_segment_fixed_size 0
  .amdhsa_kernarg_size 64
  .amdhsa_user_sgpr_count 2
  .amdhsa_user_sgpr_kernarg_segment_ptr 1
  .amdhsa_system_sgpr_workgroup_id_x 1
.end_amdhsa_kernel
```
